```python
import torch

def _softmax(x, axis=-1):
    return torch.softmax(x, dim=axis)

def _gelu(x):
    return torch.nn.functional.gelu(x, approximate='tanh')

def _silu(x):
    return torch.nn.functional.silu(x)

def _sigmoid(x):
    return torch.sigmoid(x)

def _layernorm(x, axis=-1, eps=1e-05):
    m = x.mean(dim=axis, keepdim=True)
    v = x.var(dim=axis, keepdim=True, unbiased=False)
    return (x - m) / torch.sqrt(v + eps)

def _scatter_add(tgt, idx, src, axis=0):
    return tgt.clone().index_add_(axis, idx, src)

def _segment_sum(src, seg, n):
    out = torch.zeros((n,) + src.shape[1:], dtype=src.dtype)
    return out.index_add_(0, seg, src)

def _pad(x, pw):
    flat = tuple((v for pair in reversed(pw) for v in pair))
    return torch.nn.functional.pad(x, flat)
kernel_name = 'standalone__factorization_afm__recsys'

def setup_inputs():

    _w = lambda a: (lambda t: t.to(torch.bfloat16) if t.is_floating_point() else t)(torch.as_tensor(a))
    B, F, D, V = (4096, 26, 64, min(1000, 100000))
    A = D
    ii, jj = tuple(torch.triu_indices(F, F, 1).unbind(0))
    return {'idx': _w((lambda lo, hi, *s: torch.randint(lo, hi, s))(0, V, B, F).to(torch.int64)), 'table': _w((lambda *s: torch.randn(*s, dtype=torch.bfloat16) * 1.6)(V, D)), 'ii': _w(ii.to(torch.int64)), 'jj': _w(jj.to(torch.int64)), 'W': _w((lambda *s: torch.randn(*s, dtype=torch.bfloat16) * 0.4)(D, A) * (1.0 / D ** 0.5)), 'b': _w((lambda *s: torch.randn(*s, dtype=torch.bfloat16) * 0.4)(A)), 'h': _w((lambda *s: torch.randn(*s, dtype=torch.bfloat16) * 0.4)(A)), 'p': _w((lambda *s: torch.randn(*s, dtype=torch.bfloat16) * 1.6)(D))}

def reference(idx, table, ii, jj, W, b, h, p):
    emb = table[idx]
    ei = emb[:, ii, :].clone()
    ej = emb[:, jj, :].clone()
    pair = ei * ej
    hid = pair @ W + b
    hid = 0.5 * (hid + torch.abs(hid))
    e = hid @ h
    alpha = _softmax(e, axis=-1)
    pooled = torch.einsum('bp,bpd->bd', alpha, pair)
    return pooled @ p
```

```asm
; @launch grid=(256,1,1) block=(512,1,1) lds=71040
.amdgcn_target "amdgcn-amd-amdhsa--gfx950"
.text
.globl standalone__factorization_afm__recsys_kernel
.p2align 8
.type standalone__factorization_afm__recsys_kernel,@function
standalone__factorization_afm__recsys_kernel:
  s_cmp_ge_u32 s2, 256
  s_cbranch_scc1 L_end
  s_lshr_b32 s3, s2, 3
  s_and_b32 s4, s2, 7
  s_lshl_b32 s4, s4, 5
  s_add_u32 s2, s3, s4
  s_load_dwordx2 s[24:25], s[0:1], 0
  s_load_dwordx2 s[28:29], s[0:1], 8
  s_load_dwordx8 s[8:15], s[0:1], 32
  s_load_dwordx2 s[48:49], s[0:1], 64
  s_getpc_b64 s[22:23]
L_pc:
  v_lshrrev_b32 v26, 6, v0
  v_and_b32 v1, 63, v0
  v_and_b32 v27, 15, v0
  v_readfirstlane_b32 s52, v26
  v_lshl_add_u32 v27, v26, 4, v27
  v_lshlrev_b32 v27, 6, v27
  v_min_u32 v27, L_pf_end-L_pc-4, v27
  s_lshl_b32 s61, s52, 6
  s_add_u32 s61, s61, L_tbl-L_pc
  global_load_dword v103, v27, s[22:23]
  s_lshr_b32 s53, s52, 1
  s_and_b32 s54, s52, 1
  s_mul_i32 s55, s53, 28
  s_cmp_eq_u32 s53, 3
  s_cselect_b32 s56, 4, 0
  s_sub_u32 s55, s55, s56
  s_mul_i32 s56, s2, 1664
  s_add_u32 s55, s55, s56
  s_mul_i32 s56, s54, 832
  s_add_u32 s56, s55, s56
  v_lshrrev_b32 v22, 3, v1
  v_mul_u32_u24 v113, 104, v22
  v_and_b32 v23, 7, v1
  v_lshlrev_b32 v114, 4, v23
  v_lshlrev_b32 v117, 7, v23
  s_mov_b32 s26, 425984
  s_mov_b32 s27, 0x20000
  s_mov_b32 s30, 128000
  s_mov_b32 s31, 0x20000
  s_mov_b32 s50, 8192
  s_mov_b32 s51, 0x20000
  s_and_b32 s57, s2, 15
  s_lshl_b32 s57, s57, 3
  s_add_u32 s57, s57, s52
  s_lshl_b32 s57, s57, 10
  s_waitcnt lgkmcnt(0)
  buffer_load_dwordx4 v[96:99], v113, s[24:27], s56 offen
  buffer_load_dwordx3 v[100:102], v113, s[24:27], s56 offen offset:16
  buffer_load_dword v103, v117, s[28:31], s57 offen
  s_load_dwordx16 s[80:95], s[22:23], s61
  s_and_b32 s18, s52, 3
  s_mov_b32 s20, 1152
  s_mov_b32 s44, 76
  s_mov_b32 s21, 1280
  s_cmp_eq_u32 s18, 1
  s_cselect_b32 s16, s12, s10
  s_cselect_b32 s17, s13, s11
  s_cselect_b32 s19, 0x3f38aa3b, 1.0
  s_cselect_b32 s20, 1024, s20
  s_cselect_b32 s44, 72, s44
  s_cmp_eq_u32 s18, 2
  s_cselect_b32 s16, s14, s16
  s_cselect_b32 s17, s15, s17
  s_cselect_b32 s20, 896, s20
  s_cselect_b32 s44, 68, s44
  s_cmp_eq_u32 s18, 0
  s_cselect_b32 s21, 512, s21
  s_cmp_eq_u32 s18, 3
  s_cselect_b32 s21, 512, s21
  v_lshlrev_b32 v115, 4, v0
  v_lshlrev_b32 v116, 1, v1
  global_load_dwordx4 v[104:107], v115, s[8:9]
  global_load_dwordx4 v[108:111], v114, s[12:13]
  global_load_ushort v38, v116, s[16:17]
  v_lshrrev_b32 v25, 3, v0
  v_add_u32 v118, s20, v116
  v_lshlrev_b32 v119, 1, v25
  s_mul_i32 s57, s53, 2176
  s_lshl_b32 s58, s54, 7
  s_add_u32 s57, s57, s58
  s_add_u32 s57, s57, 14464
  v_mul_u32_u24 v30, 272, v23
  v_lshl_add_u32 v30, v22, 4, v30
  v_add_u32 v30, s57, v30
  v_lshrrev_b32 v26, 4, v25
  v_mul_u32_u24 v25, 192, v25
  v_lshl_add_u32 v25, v26, 5, v25
  v_add_u32 v25, v25, v114
  v_lshlrev_b32 v24, 2, v1
  v_mov_b32 v26, 0
  ds_write_b32 v24, v26 offset:0
  v_add_u32 v24, s21, v24
  v_lshrrev_b32 v31, 4, v1
  v_and_b32 v32, 15, v1
  v_lshrrev_b32 v216, 2, v32
  v_lshl_add_u32 v216, v31, 4, v216
  v_mul_u32_u24 v216, 192, v216
  v_lshl_add_u32 v216, v31, 5, v216
  v_and_b32 v26, 3, v1
  v_lshl_add_u32 v216, v26, 3, v216
  v_and_b32 v217, 0x30, v1
  v_bfe_u32 v26, v1, 4, 1
  v_lshrrev_b32 v27, 5, v1
  v_and_b32 v28, 2, v1
  v_lshlrev_b32 v28, 1, v28
  v_lshl_add_u32 v218, v26, 6, v28
  v_lshl_add_u32 v218, v27, 4, v218
  v_lshl_add_u32 v219, v27, 6, v28
  v_lshl_add_u32 v219, v26, 4, v219
  v_add_u32 v219, 1024, v219
  v_and_b32 v26, 1, v1
  v_mul_u32_u24 v26, 128, v26
  v_add_u32 v218, v218, v26
  v_add_u32 v218, 768, v218
  v_mov_b64 v[176:177], 0
  v_mov_b64 v[178:179], 0
  v_mov_b64 v[192:193], 0
  v_mov_b64 v[194:195], 0
  v_mov_b64 v[240:241], 0
  v_mov_b64 v[242:243], 0
  v_mov_b64 v[244:245], 0
  v_mov_b64 v[246:247], 0
  v_mov_b64 v[248:249], 0
  v_mov_b64 v[250:251], 0
  v_mov_b64 v[252:253], 0
  v_mov_b64 v[254:255], 0
  v_mov_b64 v[120:121], 0
  v_mov_b64 v[122:123], 0
  v_mov_b64 v[124:125], 0
  v_mov_b64 v[126:127], 0
  s_mov_b32 s32, 0xcccccccc
  s_mov_b32 s33, 0xcccccccc
  v_mov_b32 v26, 0x44444444
  v_mov_b32 v27, 0xeeeeeeee
  v_cndmask_b32 v43, v26, v27, s[32:33]
  v_mul_u32_u24 v42, 544, v31
  v_lshl_add_u32 v42, v32, 4, v42
  v_add_u32 v42, 14464, v42
  s_waitcnt lgkmcnt(0)
  s_and_b32 s57, s80, 0xffff
  s_lshr_b32 s58, s80, 16
  v_add_u32 v220, s57, v42
  v_add_u32 v221, s58, v42
  s_and_b32 s57, s81, 0xffff
  s_lshr_b32 s58, s81, 16
  v_add_u32 v222, s57, v42
  v_add_u32 v223, s58, v42
  s_and_b32 s57, s82, 0xffff
  s_lshr_b32 s58, s82, 16
  v_add_u32 v40, s57, v42
  v_add_u32 v41, s58, v42
  s_mov_b32 m0, 0
  s_mov_b32 s60, s93
  s_mov_b32 s58, -1
  s_mov_b32 s59, s94
  v_mov_b32 v45, 0xff800000
  v_mov_b64 v[46:47], 0
  v_cndmask_b32 v44, 0, v45, s[58:59]
  v_mov_b32 v45, 0
  v_mov_b64 v[34:35], 0
  s_waitcnt vmcnt(4)
  v_lshl_add_u32 v96, v96, 7, v114
  buffer_load_dwordx4 v[48:51], v96, s[28:31], 0 offen
  v_lshl_add_u32 v97, v97, 7, v114
  buffer_load_dwordx4 v[52:55], v97, s[28:31], 0 offen
  v_lshl_add_u32 v98, v98, 7, v114
  v_lshl_add_u32 v99, v99, 7, v114
  v_lshl_add_u32 v100, v100, 7, v114
  v_lshl_add_u32 v101, v101, 7, v114
  v_lshl_add_u32 v102, v102, 7, v114
  s_waitcnt vmcnt(2)
  v_dot2_f32_bf16 v236, v104, v108, 0
  v_lshlrev_b32 v224, 16, v104
  v_and_b32 v225, 0xffff0000, v104
  v_dot2_f32_bf16 v236, v105, v109, v236
  v_lshlrev_b32 v226, 16, v105
  v_and_b32 v227, 0xffff0000, v105
  v_dot2_f32_bf16 v236, v106, v110, v236
  v_lshlrev_b32 v228, 16, v106
  v_and_b32 v229, 0xffff0000, v106
  v_dot2_f32_bf16 v236, v107, v111, v236
  v_lshlrev_b32 v230, 16, v107
  v_and_b32 v231, 0xffff0000, v107
  v_lshlrev_b32 v38, 16, v38
  v_cvt_pk_f16_f32 v232, v224, v225
  v_cvt_pk_f16_f32 v233, v226, v227
  v_cvt_pk_f16_f32 v234, v228, v229
  v_cvt_pk_f16_f32 v235, v230, v231
  v_add_f32_dpp v236, v236, v236 quad_perm:[1,0,3,2] row_mask:0xf bank_mask:0xf
  ds_write_b128 v25, v[232:235] offset:2048
  ds_write_b32 v24, v38
  v_add_f32_dpp v236, v236, v236 quad_perm:[2,3,0,1] row_mask:0xf bank_mask:0xf
  v_mul_f32 v38, s19, v38
  s_nop 0
  v_add_f32_dpp v236, v236, v236 row_half_mirror row_mask:0xf bank_mask:0xf
  v_cvt_f16_f32 v38, v38
  v_mul_f32 v236, 0x3f38aa3b, v236
  ds_write_b16 v118, v38
  v_cvt_f16_f32 v236, v236
  ds_write_b16 v119, v236 offset:768
  s_waitcnt lgkmcnt(0)
  s_barrier
  s_mov_b32 exec_lo, 0x000f000f
  s_mov_b32 exec_hi, 0x000f000f
  ds_read2_b32 v[176:177], v218 offset0:0 offset1:2
  ds_read2_b32 v[178:179], v218 offset0:8 offset1:10
  s_mov_b32 exec_lo, 0x00050005
  s_mov_b32 exec_hi, 0x00050005
  ds_read2_b32 v[192:193], v219 offset0:0 offset1:8
  ds_read2_b32 v[194:195], v219 offset0:2 offset1:10
  s_mov_b64 exec, -1
  buffer_load_dwordx4 v[56:59], v98, s[28:31], 0 offen
  ds_read_b64_tr_b16 v[128:129], v216 offset:2048
  ds_read_b64_tr_b16 v[130:131], v216 offset:2816
  ds_read_b64_tr_b16 v[132:133], v216 offset:3584
  ds_read_b64_tr_b16 v[134:135], v216 offset:4352
  buffer_load_dwordx4 v[60:63], v99, s[28:31], 0 offen
  ds_read_b64_tr_b16 v[136:137], v216 offset:2080
  ds_read_b64_tr_b16 v[138:139], v216 offset:2848
  ds_read_b64_tr_b16 v[140:141], v216 offset:3616
  ds_read_b64_tr_b16 v[142:143], v216 offset:4384
  buffer_load_dwordx4 v[64:67], v100, s[28:31], 0 offen
  ds_read_b64_tr_b16 v[144:145], v216 offset:2112
  ds_read_b64_tr_b16 v[146:147], v216 offset:2880
  ds_read_b64_tr_b16 v[148:149], v216 offset:3648
  ds_read_b64_tr_b16 v[150:151], v216 offset:4416
  buffer_load_dwordx4 v[68:71], v101, s[28:31], 0 offen
  ds_read_b64_tr_b16 v[152:153], v216 offset:2144
  ds_read_b64_tr_b16 v[154:155], v216 offset:2912
  ds_read_b64_tr_b16 v[156:157], v216 offset:3680
  ds_read_b64_tr_b16 v[158:159], v216 offset:4448
  buffer_load_dwordx4 v[72:75], v102, s[28:31], 0 offen
  ds_read_b128 v[160:163], v217 offset:512
  ds_read_b128 v[164:167], v217 offset:576
  ds_read_b128 v[168:171], v217 offset:640
  ds_read_b128 v[172:175], v217 offset:704
  s_waitcnt vmcnt(6)
  v_lshlrev_b32 v224, 16, v48
  v_and_b32 v225, 0xffff0000, v48
  v_lshlrev_b32 v226, 16, v49
  v_and_b32 v227, 0xffff0000, v49
  v_lshlrev_b32 v228, 16, v50
  v_and_b32 v229, 0xffff0000, v50
  v_lshlrev_b32 v230, 16, v51
  v_and_b32 v231, 0xffff0000, v51
  v_cvt_pk_f16_f32 v48, v224, v225
  v_cvt_pk_f16_f32 v49, v226, v227
  v_cvt_pk_f16_f32 v50, v228, v229
  v_cvt_pk_f16_f32 v51, v230, v231
  ds_write_b128 v30, v[48:51] offset:0
  s_waitcnt lgkmcnt(14)
  v_mov_b32_dpp v180, v176 row_shr:4 row_mask:0xf bank_mask:0xf bound_ctrl:0
  v_mov_b32_dpp v181, v177 row_shr:4 row_mask:0xf bank_mask:0xf bound_ctrl:0
  v_mov_b32_dpp v182, v178 row_shr:4 row_mask:0xf bank_mask:0xf bound_ctrl:0
  v_mov_b32_dpp v183, v179 row_shr:4 row_mask:0xf bank_mask:0xf bound_ctrl:0
  v_mov_b32_dpp v196, v192 row_shr:4 row_mask:0xf bank_mask:0xf bound_ctrl:0
  v_mov_b32_dpp v197, v193 row_shr:4 row_mask:0xf bank_mask:0xf bound_ctrl:0
  v_mov_b32_dpp v198, v194 row_shr:4 row_mask:0xf bank_mask:0xf bound_ctrl:0
  v_mov_b32_dpp v199, v195 row_shr:4 row_mask:0xf bank_mask:0xf bound_ctrl:0
  v_mov_b32_dpp v184, v176 row_shr:8 row_mask:0xf bank_mask:0xf bound_ctrl:0
  v_mov_b32_dpp v185, v177 row_shr:8 row_mask:0xf bank_mask:0xf bound_ctrl:0
  v_mov_b32_dpp v186, v178 row_shr:8 row_mask:0xf bank_mask:0xf bound_ctrl:0
  v_mov_b32_dpp v187, v179 row_shr:8 row_mask:0xf bank_mask:0xf bound_ctrl:0
  v_mov_b32_dpp v200, v192 row_shr:8 row_mask:0xf bank_mask:0xf bound_ctrl:0
  v_mov_b32_dpp v201, v193 row_shr:8 row_mask:0xf bank_mask:0xf bound_ctrl:0
  v_mov_b32_dpp v202, v194 row_shr:8 row_mask:0xf bank_mask:0xf bound_ctrl:0
  v_mov_b32_dpp v203, v195 row_shr:8 row_mask:0xf bank_mask:0xf bound_ctrl:0
  v_mov_b32_dpp v188, v176 row_shr:12 row_mask:0xf bank_mask:0xf bound_ctrl:0
  v_mov_b32_dpp v189, v177 row_shr:12 row_mask:0xf bank_mask:0xf bound_ctrl:0
  v_mov_b32_dpp v190, v178 row_shr:12 row_mask:0xf bank_mask:0xf bound_ctrl:0
  v_mov_b32_dpp v191, v179 row_shr:12 row_mask:0xf bank_mask:0xf bound_ctrl:0
  v_mov_b32_dpp v204, v192 row_shr:12 row_mask:0xf bank_mask:0xf bound_ctrl:0
  v_mov_b32_dpp v205, v193 row_shr:12 row_mask:0xf bank_mask:0xf bound_ctrl:0
  v_mov_b32_dpp v206, v194 row_shr:12 row_mask:0xf bank_mask:0xf bound_ctrl:0
  v_mov_b32_dpp v207, v195 row_shr:12 row_mask:0xf bank_mask:0xf bound_ctrl:0
  s_waitcnt vmcnt(5)
  v_lshlrev_b32 v224, 16, v52
  v_and_b32 v225, 0xffff0000, v52
  v_lshlrev_b32 v226, 16, v53
  v_and_b32 v227, 0xffff0000, v53
  v_lshlrev_b32 v228, 16, v54
  v_and_b32 v229, 0xffff0000, v54
  v_lshlrev_b32 v230, 16, v55
  v_and_b32 v231, 0xffff0000, v55
  v_cvt_pk_f16_f32 v52, v224, v225
  v_cvt_pk_f16_f32 v53, v226, v227
  v_cvt_pk_f16_f32 v54, v228, v229
  v_cvt_pk_f16_f32 v55, v230, v231
  ds_write_b128 v30, v[52:55] offset:8704
  s_waitcnt vmcnt(4)
  v_lshlrev_b32 v224, 16, v56
  v_and_b32 v225, 0xffff0000, v56
  v_lshlrev_b32 v226, 16, v57
  v_and_b32 v227, 0xffff0000, v57
  v_lshlrev_b32 v228, 16, v58
  v_and_b32 v229, 0xffff0000, v58
  v_lshlrev_b32 v230, 16, v59
  v_and_b32 v231, 0xffff0000, v59
  v_cvt_pk_f16_f32 v56, v224, v225
  v_cvt_pk_f16_f32 v57, v226, v227
  v_cvt_pk_f16_f32 v58, v228, v229
  v_cvt_pk_f16_f32 v59, v230, v231
  ds_write_b128 v30, v[56:59] offset:17408
  s_waitcnt vmcnt(3)
  v_lshlrev_b32 v224, 16, v60
  v_and_b32 v225, 0xffff0000, v60
  v_lshlrev_b32 v226, 16, v61
  v_and_b32 v227, 0xffff0000, v61
  v_lshlrev_b32 v228, 16, v62
  v_and_b32 v229, 0xffff0000, v62
  v_lshlrev_b32 v230, 16, v63
  v_and_b32 v231, 0xffff0000, v63
  v_cvt_pk_f16_f32 v60, v224, v225
  v_cvt_pk_f16_f32 v61, v226, v227
  v_cvt_pk_f16_f32 v62, v228, v229
  v_cvt_pk_f16_f32 v63, v230, v231
  ds_write_b128 v30, v[60:63] offset:26112
  s_waitcnt vmcnt(2)
  v_lshlrev_b32 v224, 16, v64
  v_and_b32 v225, 0xffff0000, v64
  v_lshlrev_b32 v226, 16, v65
  v_and_b32 v227, 0xffff0000, v65
  v_lshlrev_b32 v228, 16, v66
  v_and_b32 v229, 0xffff0000, v66
  v_lshlrev_b32 v230, 16, v67
  v_and_b32 v231, 0xffff0000, v67
  v_cvt_pk_f16_f32 v64, v224, v225
  v_cvt_pk_f16_f32 v65, v226, v227
  v_cvt_pk_f16_f32 v66, v228, v229
  v_cvt_pk_f16_f32 v67, v230, v231
  ds_write_b128 v30, v[64:67] offset:34816
  s_waitcnt vmcnt(1)
  v_lshlrev_b32 v224, 16, v68
  v_and_b32 v225, 0xffff0000, v68
  v_lshlrev_b32 v226, 16, v69
  v_and_b32 v227, 0xffff0000, v69
  v_lshlrev_b32 v228, 16, v70
  v_and_b32 v229, 0xffff0000, v70
  v_lshlrev_b32 v230, 16, v71
  v_and_b32 v231, 0xffff0000, v71
  v_cvt_pk_f16_f32 v68, v224, v225
  v_cvt_pk_f16_f32 v69, v226, v227
  v_cvt_pk_f16_f32 v70, v228, v229
  v_cvt_pk_f16_f32 v71, v230, v231
  ds_write_b128 v30, v[68:71] offset:43520
  s_cmp_ge_u32 s53, 2
  s_cbranch_scc1 L_skip6
  s_waitcnt vmcnt(0)
  v_lshlrev_b32 v224, 16, v72
  v_and_b32 v225, 0xffff0000, v72
  v_lshlrev_b32 v226, 16, v73
  v_and_b32 v227, 0xffff0000, v73
  v_lshlrev_b32 v228, 16, v74
  v_and_b32 v229, 0xffff0000, v74
  v_lshlrev_b32 v230, 16, v75
  v_and_b32 v231, 0xffff0000, v75
  v_cvt_pk_f16_f32 v72, v224, v225
  v_cvt_pk_f16_f32 v73, v226, v227
  v_cvt_pk_f16_f32 v74, v228, v229
  v_cvt_pk_f16_f32 v75, v230, v231
  ds_write_b128 v30, v[72:75] offset:52224
  v_and_b32 v238, 0x7fff7fff, v48
  v_and_b32 v237, 0x7fff7fff, v232
  v_and_b32 v38, 0x7fff, v38
  v_lshrrev_b32 v239, 3, v1
  v_max_u16_sdwa v238, v238, v238 dst_sel:DWORD dst_unused:UNUSED_PAD src0_sel:WORD_0 src1_sel:WORD_1
  v_max_u16_sdwa v237, v237, v237 dst_sel:DWORD dst_unused:UNUSED_PAD src0_sel:WORD_0 src1_sel:WORD_1
  s_lshl_b32 s57, s54, 5
  v_lshl_add_u32 v239, v239, 2, s57
  v_mov_b32 v22, 1
  v_mov_b32 v23, 76
  v_cmp_le_u32 vcc, 0x2800, v238
  v_mov_b32 v24, 64
  v_mov_b32 v25, s44
  v_cndmask_b32 v239, v23, v239, vcc
  v_cmp_le_u32 vcc, 0x1c00, v237
  s_nop 1
  v_cndmask_b32 v24, v23, v24, vcc
  v_cmp_le_u32 vcc, 0x2400, v38
  ds_write_b32 v239, v22 offset:0
  ds_write_b32 v24, v22
  v_cndmask_b32 v25, v23, v25, vcc
  ds_write_b32 v25, v22
L_skip6:
  s_cmp_lt_u32 s52, 4
  s_cbranch_scc1 L_noprio
  s_setprio 1
L_noprio:
  s_waitcnt vmcnt(0) lgkmcnt(0)
  s_barrier
  ds_read_b128 v[64:67], v220 offset:0
  ds_read_b128 v[68:71], v220 offset:272
  ds_read_b128 v[80:83], v222 offset:0
  ds_read_b128 v[84:87], v222 offset:272
  ds_read_b128 v[72:75], v221 offset:0
  ds_read_b128 v[76:79], v221 offset:272
  ds_read_b128 v[88:91], v223 offset:0
  ds_read_b128 v[92:95], v223 offset:272
  ds_read_b128 v[96:99], v40 offset:0
  ds_read_b128 v[100:103], v40 offset:272
  s_waitcnt lgkmcnt(7)
  v_pk_mul_f16 v112, v80, v64
  v_pk_mul_f16 v113, v81, v65
  v_pk_mul_f16 v114, v82, v66
  v_pk_mul_f16 v115, v83, v67
  s_waitcnt lgkmcnt(6)
  v_pk_mul_f16 v116, v84, v68
  v_pk_mul_f16 v117, v85, v69
  v_pk_mul_f16 v118, v86, v70
  v_pk_mul_f16 v119, v87, v71
  s_waitcnt lgkmcnt(5)
  v_mov_b64 v[104:105], v[72:73]
  v_mov_b64 v[106:107], v[74:75]
  s_waitcnt lgkmcnt(4)
  v_mov_b64 v[108:109], v[76:77]
  v_mov_b64 v[110:111], v[78:79]
  s_waitcnt lgkmcnt(2)
  s_branch L_slot2
.p2align 6
L_loop:
  v_mfma_f32_16x16x32_f16 v[224:227], v[128:131], v[112:115], v[160:163]
  v_cvt_pk_f16_f32 v208, |v240|, |v241|
  v_cvt_pk_f16_f32 v209, |v242|, |v243|
  v_smfmac_f32_16x16x64_f16 v[44:47], v[188:191], v[120:127], v43
  s_movrels_b32 s57, s83
  s_add_u32 m0, m0, 1
  v_mfma_f32_16x16x32_f16 v[224:227], v[132:135], v[116:119], v[224:227]
  v_cvt_pk_f16_f32 v210, |v244|, |v245|
  v_cvt_pk_f16_f32 v211, |v246|, |v247|
  v_mfma_f32_16x16x32_f16 v[228:231], v[136:139], v[112:115], v[164:167]
  v_cvt_pk_f16_f32 v212, |v248|, |v249|
  v_cvt_pk_f16_f32 v213, |v250|, |v251|
  s_and_b32 s58, s57, 0xffff
  s_lshr_b32 s59, s57, 16
  v_mfma_f32_16x16x32_f16 v[228:231], v[140:143], v[116:119], v[228:231]
  v_cvt_pk_f16_f32 v214, |v252|, |v253|
  v_cvt_pk_f16_f32 v215, |v254|, |v255|
  v_mfma_f32_16x16x32_f16 v[232:235], v[144:147], v[112:115], v[168:171]
  s_waitcnt lgkmcnt(0)
  v_pk_mul_f16 v120, v72, v104
  v_pk_mul_f16 v121, v73, v105
  v_smfmac_f32_16x16x64_f16 v[44:47], v[204:207], v[208:215], v43
  v_add_u32 v40, s58, v42
  v_add_u32 v41, s59, v42
  v_mfma_f32_16x16x32_f16 v[232:235], v[148:151], v[116:119], v[232:235]
  v_pk_mul_f16 v122, v74, v106
  v_pk_mul_f16 v123, v75, v107
  v_mfma_f32_16x16x32_f16 v[236:239], v[152:155], v[112:115], v[172:175]
  v_pk_mul_f16 v124, v76, v108
  v_pk_mul_f16 v125, v77, v109
  v_mfma_f32_16x16x32_f16 v[236:239], v[156:159], v[116:119], v[236:239]
  v_pk_mul_f16 v126, v78, v110
  v_pk_mul_f16 v127, v79, v111
  v_add_f32 v36, v44, v46
  v_add_f32 v37, v45, v47
  v_mov_b64 v[44:45], 0
  v_mov_b64 v[46:47], 0
  v_mfma_f32_16x16x32_f16 v[240:243], v[128:131], v[120:123], v[160:163]
  v_cvt_pk_f16_f32 v208, |v224|, |v225|
  v_cvt_pk_f16_f32 v209, |v226|, |v227|
  v_exp_f32 v33, v36
  v_smfmac_f32_16x16x64_f16 v[44:47], v[176:179], v[112:119], v43
  v_add_f32 v34, v34, v33
  v_mfma_f32_16x16x32_f16 v[240:243], v[132:135], v[124:127], v[240:243]
  v_cvt_pk_f16_f32 v210, |v228|, |v229|
  v_cvt_pk_f16_f32 v211, |v230|, |v231|
  v_mfma_f32_16x16x32_f16 v[244:247], v[136:139], v[120:123], v[164:167]
  v_cvt_pk_f16_f32 v212, |v232|, |v233|
  v_cvt_pk_f16_f32 v213, |v234|, |v235|
  v_mfma_f32_16x16x32_f16 v[244:247], v[140:143], v[124:127], v[244:247]
  v_cvt_pk_f16_f32 v214, |v236|, |v237|
  v_cvt_pk_f16_f32 v215, |v238|, |v239|
  v_mfma_f32_16x16x32_f16 v[248:251], v[144:147], v[120:123], v[168:171]
  v_pk_mul_f16 v112, v80, v96
  v_pk_mul_f16 v113, v81, v97
  v_smfmac_f32_16x16x64_f16 v[44:47], v[192:195], v[208:215], v43
  v_fma_f32 v35, v33, v37, v35
  v_mfma_f32_16x16x32_f16 v[248:251], v[148:151], v[124:127], v[248:251]
  v_pk_mul_f16 v114, v82, v98
  v_pk_mul_f16 v115, v83, v99
  v_mfma_f32_16x16x32_f16 v[252:255], v[152:155], v[120:123], v[172:175]
  v_pk_mul_f16 v116, v84, v100
  v_pk_mul_f16 v117, v85, v101
  s_cmp_eq_u32 s60, s95
  v_mfma_f32_16x16x32_f16 v[252:255], v[156:159], v[124:127], v[252:255]
  v_pk_mul_f16 v118, v86, v102
  v_pk_mul_f16 v119, v87, v103
  ds_read_b128 v[96:99], v40 offset:0
  ds_read_b128 v[100:103], v40 offset:272
  s_cbranch_scc1 L_ep1
L_slot2:
  v_mfma_f32_16x16x32_f16 v[224:227], v[128:131], v[112:115], v[160:163]
  v_cvt_pk_f16_f32 v208, |v240|, |v241|
  v_cvt_pk_f16_f32 v209, |v242|, |v243|
  v_smfmac_f32_16x16x64_f16 v[44:47], v[180:183], v[120:127], v43
  v_mfma_f32_16x16x32_f16 v[224:227], v[132:135], v[116:119], v[224:227]
  v_cvt_pk_f16_f32 v210, |v244|, |v245|
  v_cvt_pk_f16_f32 v211, |v246|, |v247|
  v_mfma_f32_16x16x32_f16 v[228:231], v[136:139], v[112:115], v[164:167]
  v_cvt_pk_f16_f32 v212, |v248|, |v249|
  v_cvt_pk_f16_f32 v213, |v250|, |v251|
  v_mfma_f32_16x16x32_f16 v[228:231], v[140:143], v[116:119], v[228:231]
  v_cvt_pk_f16_f32 v214, |v252|, |v253|
  v_cvt_pk_f16_f32 v215, |v254|, |v255|
  v_mfma_f32_16x16x32_f16 v[232:235], v[144:147], v[112:115], v[168:171]
  v_pk_mul_f16 v120, v88, v104
  v_pk_mul_f16 v121, v89, v105
  v_smfmac_f32_16x16x64_f16 v[44:47], v[196:199], v[208:215], v43
  v_mfma_f32_16x16x32_f16 v[232:235], v[148:151], v[116:119], v[232:235]
  v_pk_mul_f16 v122, v90, v106
  v_pk_mul_f16 v123, v91, v107
  v_mfma_f32_16x16x32_f16 v[236:239], v[152:155], v[112:115], v[172:175]
  v_pk_mul_f16 v124, v92, v108
  v_pk_mul_f16 v125, v93, v109
  v_mfma_f32_16x16x32_f16 v[236:239], v[156:159], v[116:119], v[236:239]
  v_pk_mul_f16 v126, v94, v110
  v_pk_mul_f16 v127, v95, v111
  ds_read_b128 v[104:107], v41 offset:0
  ds_read_b128 v[108:111], v41 offset:272
  v_mfma_f32_16x16x32_f16 v[240:243], v[128:131], v[120:123], v[160:163]
  v_cvt_pk_f16_f32 v208, |v224|, |v225|
  v_cvt_pk_f16_f32 v209, |v226|, |v227|
  v_smfmac_f32_16x16x64_f16 v[44:47], v[184:187], v[112:119], v43
  v_mfma_f32_16x16x32_f16 v[240:243], v[132:135], v[124:127], v[240:243]
  v_cvt_pk_f16_f32 v210, |v228|, |v229|
  v_cvt_pk_f16_f32 v211, |v230|, |v231|
  v_mfma_f32_16x16x32_f16 v[244:247], v[136:139], v[120:123], v[164:167]
  v_cvt_pk_f16_f32 v212, |v232|, |v233|
  v_cvt_pk_f16_f32 v213, |v234|, |v235|
  v_mfma_f32_16x16x32_f16 v[244:247], v[140:143], v[124:127], v[244:247]
  v_cvt_pk_f16_f32 v214, |v236|, |v237|
  v_cvt_pk_f16_f32 v215, |v238|, |v239|
  v_mfma_f32_16x16x32_f16 v[248:251], v[144:147], v[120:123], v[168:171]
  s_waitcnt lgkmcnt(2)
  v_pk_mul_f16 v112, v64, v96
  v_pk_mul_f16 v113, v65, v97
  v_smfmac_f32_16x16x64_f16 v[44:47], v[200:203], v[208:215], v43
  v_mfma_f32_16x16x32_f16 v[248:251], v[148:151], v[124:127], v[248:251]
  v_pk_mul_f16 v114, v66, v98
  v_pk_mul_f16 v115, v67, v99
  v_mfma_f32_16x16x32_f16 v[252:255], v[152:155], v[120:123], v[172:175]
  v_pk_mul_f16 v116, v68, v100
  s_sub_u32 s60, s60, 1
  s_cmp_eq_u32 s60, 2
  s_cbranch_scc1 L_prio
L_keep:
  s_cmp_lg_u32 s60, 0
  v_pk_mul_f16 v117, v69, v101
  v_mfma_f32_16x16x32_f16 v[252:255], v[156:159], v[124:127], v[252:255]
  v_pk_mul_f16 v118, v70, v102
  v_pk_mul_f16 v119, v71, v103
  s_cbranch_scc1 L_loop
  v_smfmac_f32_16x16x64_f16 v[44:47], v[188:191], v[120:127], v43
  v_lshrrev_b32 v12, 4, v0
  v_mul_u32_u24 v12, 17, v12
  v_and_b32 v13, 15, v0
  v_add_lshl_u32 v12, v12, v13, 3
  v_and_b32 v28, 31, v1
  v_cvt_pk_f16_f32 v208, |v240|, |v241|
  v_cvt_pk_f16_f32 v209, |v242|, |v243|
  v_cvt_pk_f16_f32 v210, |v244|, |v245|
  v_cvt_pk_f16_f32 v211, |v246|, |v247|
  v_cvt_pk_f16_f32 v212, |v248|, |v249|
  v_cvt_pk_f16_f32 v213, |v250|, |v251|
  v_cvt_pk_f16_f32 v214, |v252|, |v253|
  v_cvt_pk_f16_f32 v215, |v254|, |v255|
  v_mul_u32_u24 v13, 17, v28
  v_lshrrev_b32 v14, 5, v1
  v_smfmac_f32_16x16x64_f16 v[44:47], v[204:207], v[208:215], v43
  s_lshl_b32 s57, s52, 1
  v_add_u32 v14, s57, v14
  v_add_lshl_u32 v13, v13, v14, 3
  v_lshlrev_b32 v15, 2, v14
  s_lshl_b32 s57, s2, 4
  v_add_u32 v14, s57, v14
  v_lshlrev_b32 v14, 1, v14
  v_mov_b32 v19, 0
  v_add_f32 v36, v44, v46
  v_add_f32 v37, v45, v47
  v_exp_f32 v33, v36
  v_mov_b32 v26, 0x1f800000
  v_add_f32 v34, v34, v33
  v_fma_f32 v35, v33, v37, v35
  v_mov_b32 v27, 0x71800000
  v_mov_b32 v25, 0x207
  v_cmp_eq_u32 s[58:59], 0, v28
L_tail:
  ds_write_b64 v12, v[34:35] offset:2048
  s_waitcnt lgkmcnt(0)
  s_barrier
  ds_read_b64 v[16:17], v13 offset:2048
  ds_read_b32 v18, v15 offset:0
  ds_read_b96 v[20:22], v19 offset:64
  s_waitcnt lgkmcnt(2)
  v_add_f32_dpp v16, v16, v16 quad_perm:[1,0,3,2] row_mask:0xf bank_mask:0xf
  v_add_f32_dpp v17, v17, v17 quad_perm:[1,0,3,2] row_mask:0xf bank_mask:0xf
  s_nop 0
  v_add_f32_dpp v16, v16, v16 quad_perm:[2,3,0,1] row_mask:0xf bank_mask:0xf
  v_add_f32_dpp v17, v17, v17 quad_perm:[2,3,0,1] row_mask:0xf bank_mask:0xf
  s_nop 0
  v_add_f32_dpp v16, v16, v16 row_half_mirror row_mask:0xf bank_mask:0xf
  v_add_f32_dpp v17, v17, v17 row_half_mirror row_mask:0xf bank_mask:0xf
  s_nop 0
  v_add_f32_dpp v16, v16, v16 row_mirror row_mask:0xf bank_mask:0xf
  v_add_f32_dpp v17, v17, v17 row_mirror row_mask:0xf bank_mask:0xf
  s_nop 0
  v_mov_b32 v30, v16
  v_mov_b32 v31, v17
  s_nop 0
  v_permlane16_swap_b32 v16, v30
  v_permlane16_swap_b32 v17, v31
  s_mov_b64 exec, s[58:59]
  v_add_f32 v16, v16, v30
  v_add_f32 v17, v17, v31
  v_rcp_f32 v30, v16
  v_med3_f32 v26, v16, v26, v27
  v_mul_f32 v17, v17, v30
  v_cmp_neq_f32 vcc, v26, v16
  v_cvt_pk_bf16_f32 v24, v17, v17
  v_cmp_class_f32 s[46:47], v17, v25
  buffer_store_short v24, v14, s[48:51], 0 offen
  s_waitcnt lgkmcnt(0)
  v_and_b32 v18, v18, v20
  v_and_b32 v21, v21, v22
  v_and_b32 v18, v18, v21
  v_cmp_eq_u32 s[44:45], 0, v18

  s_or_b64 s[46:47], s[46:47], vcc
  s_or_b64 s[44:45], s[44:45], s[46:47]
  s_and_b64 s[44:45], s[44:45], exec
  s_cbranch_scc1 L_slow
L_end:
  s_endpgm
L_ep1:
  v_smfmac_f32_16x16x64_f16 v[44:47], v[180:183], v[120:127], v43
  v_lshrrev_b32 v12, 4, v0
  v_mul_u32_u24 v12, 17, v12
  v_and_b32 v13, 15, v0
  v_add_lshl_u32 v12, v12, v13, 3
  v_and_b32 v28, 31, v1
  v_cvt_pk_f16_f32 v208, |v240|, |v241|
  v_cvt_pk_f16_f32 v209, |v242|, |v243|
  v_cvt_pk_f16_f32 v210, |v244|, |v245|
  v_cvt_pk_f16_f32 v211, |v246|, |v247|
  v_cvt_pk_f16_f32 v212, |v248|, |v249|
  v_cvt_pk_f16_f32 v213, |v250|, |v251|
  v_cvt_pk_f16_f32 v214, |v252|, |v253|
  v_cvt_pk_f16_f32 v215, |v254|, |v255|
  v_mul_u32_u24 v13, 17, v28
  v_lshrrev_b32 v14, 5, v1
  v_smfmac_f32_16x16x64_f16 v[44:47], v[196:199], v[208:215], v43
  s_lshl_b32 s57, s52, 1
  v_add_u32 v14, s57, v14
  v_add_lshl_u32 v13, v13, v14, 3
  v_lshlrev_b32 v15, 2, v14
  s_lshl_b32 s57, s2, 4
  v_add_u32 v14, s57, v14
  v_lshlrev_b32 v14, 1, v14
  v_mov_b32 v19, 0
  v_add_f32 v36, v44, v46
  v_add_f32 v37, v45, v47
  v_exp_f32 v33, v36
  s_mov_b32 exec_hi, 0
  v_add_f32 v34, v34, v33
  v_fma_f32 v35, v33, v37, v35
  s_mov_b32 exec_hi, -1
  v_mov_b32 v26, 0x1f800000
  v_mov_b32 v27, 0x71800000
  v_mov_b32 v25, 0x207
  v_cmp_eq_u32 s[58:59], 0, v28
  s_branch L_tail
L_prio:
  s_setprio 0
  s_branch L_keep
L_pf_end:
L_slow:
  s_mov_b64 exec, -1
  v_lshlrev_b32 v2, 1, v1
  v_add_u32 v3, 4096, v2
  global_load_ushort v128, v2, s[8:9] offset:0
  global_load_ushort v129, v2, s[8:9] offset:128
  global_load_ushort v130, v2, s[8:9] offset:256
  global_load_ushort v131, v2, s[8:9] offset:384
  global_load_ushort v132, v2, s[8:9] offset:512
  global_load_ushort v133, v2, s[8:9] offset:640
  global_load_ushort v134, v2, s[8:9] offset:768
  global_load_ushort v135, v2, s[8:9] offset:896
  global_load_ushort v136, v2, s[8:9] offset:1024
  global_load_ushort v137, v2, s[8:9] offset:1152
  global_load_ushort v138, v2, s[8:9] offset:1280
  global_load_ushort v139, v2, s[8:9] offset:1408
  global_load_ushort v140, v2, s[8:9] offset:1536
  global_load_ushort v141, v2, s[8:9] offset:1664
  global_load_ushort v142, v2, s[8:9] offset:1792
  global_load_ushort v143, v2, s[8:9] offset:1920
  global_load_ushort v144, v2, s[8:9] offset:2048
  global_load_ushort v145, v2, s[8:9] offset:2176
  global_load_ushort v146, v2, s[8:9] offset:2304
  global_load_ushort v147, v2, s[8:9] offset:2432
  global_load_ushort v148, v2, s[8:9] offset:2560
  global_load_ushort v149, v2, s[8:9] offset:2688
  global_load_ushort v150, v2, s[8:9] offset:2816
  global_load_ushort v151, v2, s[8:9] offset:2944
  global_load_ushort v152, v2, s[8:9] offset:3072
  global_load_ushort v153, v2, s[8:9] offset:3200
  global_load_ushort v154, v2, s[8:9] offset:3328
  global_load_ushort v155, v2, s[8:9] offset:3456
  global_load_ushort v156, v2, s[8:9] offset:3584
  global_load_ushort v157, v2, s[8:9] offset:3712
  global_load_ushort v158, v2, s[8:9] offset:3840
  global_load_ushort v159, v2, s[8:9] offset:3968
  global_load_ushort v160, v3, s[8:9] offset:0
  global_load_ushort v161, v3, s[8:9] offset:128
  global_load_ushort v162, v3, s[8:9] offset:256
  global_load_ushort v163, v3, s[8:9] offset:384
  global_load_ushort v164, v3, s[8:9] offset:512
  global_load_ushort v165, v3, s[8:9] offset:640
  global_load_ushort v166, v3, s[8:9] offset:768
  global_load_ushort v167, v3, s[8:9] offset:896
  global_load_ushort v168, v3, s[8:9] offset:1024
  global_load_ushort v169, v3, s[8:9] offset:1152
  global_load_ushort v170, v3, s[8:9] offset:1280
  global_load_ushort v171, v3, s[8:9] offset:1408
  global_load_ushort v172, v3, s[8:9] offset:1536
  global_load_ushort v173, v3, s[8:9] offset:1664
  global_load_ushort v174, v3, s[8:9] offset:1792
  global_load_ushort v175, v3, s[8:9] offset:1920
  global_load_ushort v176, v3, s[8:9] offset:2048
  global_load_ushort v177, v3, s[8:9] offset:2176
  global_load_ushort v178, v3, s[8:9] offset:2304
  global_load_ushort v179, v3, s[8:9] offset:2432
  global_load_ushort v180, v3, s[8:9] offset:2560
  global_load_ushort v181, v3, s[8:9] offset:2688
  global_load_ushort v182, v3, s[8:9] offset:2816
  global_load_ushort v183, v3, s[8:9] offset:2944
  global_load_ushort v184, v3, s[8:9] offset:3072
  global_load_ushort v185, v3, s[8:9] offset:3200
  global_load_ushort v186, v3, s[8:9] offset:3328
  global_load_ushort v187, v3, s[8:9] offset:3456
  global_load_ushort v188, v3, s[8:9] offset:3584
  global_load_ushort v189, v3, s[8:9] offset:3712
  global_load_ushort v190, v3, s[8:9] offset:3840
  global_load_ushort v191, v3, s[8:9] offset:3968
  global_load_ushort v100, v2, s[10:11]
  global_load_ushort v101, v2, s[12:13]
  global_load_ushort v102, v2, s[14:15]
  s_mul_i32 s36, s52, 6656
  s_add_u32 s36, s36, 14464
  v_lshlrev_b32 v4, 2, v1
  v_add_u32 v4, s36, v4
  s_waitcnt vmcnt(0)
  v_lshlrev_b32 v128, 16, v128
  v_lshlrev_b32 v129, 16, v129
  v_lshlrev_b32 v130, 16, v130
  v_lshlrev_b32 v131, 16, v131
  v_lshlrev_b32 v132, 16, v132
  v_lshlrev_b32 v133, 16, v133
  v_lshlrev_b32 v134, 16, v134
  v_lshlrev_b32 v135, 16, v135
  v_lshlrev_b32 v136, 16, v136
  v_lshlrev_b32 v137, 16, v137
  v_lshlrev_b32 v138, 16, v138
  v_lshlrev_b32 v139, 16, v139
  v_lshlrev_b32 v140, 16, v140
  v_lshlrev_b32 v141, 16, v141
  v_lshlrev_b32 v142, 16, v142
  v_lshlrev_b32 v143, 16, v143
  v_lshlrev_b32 v144, 16, v144
  v_lshlrev_b32 v145, 16, v145
  v_lshlrev_b32 v146, 16, v146
  v_lshlrev_b32 v147, 16, v147
  v_lshlrev_b32 v148, 16, v148
  v_lshlrev_b32 v149, 16, v149
  v_lshlrev_b32 v150, 16, v150
  v_lshlrev_b32 v151, 16, v151
  v_lshlrev_b32 v152, 16, v152
  v_lshlrev_b32 v153, 16, v153
  v_lshlrev_b32 v154, 16, v154
  v_lshlrev_b32 v155, 16, v155
  v_lshlrev_b32 v156, 16, v156
  v_lshlrev_b32 v157, 16, v157
  v_lshlrev_b32 v158, 16, v158
  v_lshlrev_b32 v159, 16, v159
  v_lshlrev_b32 v160, 16, v160
  v_lshlrev_b32 v161, 16, v161
  v_lshlrev_b32 v162, 16, v162
  v_lshlrev_b32 v163, 16, v163
  v_lshlrev_b32 v164, 16, v164
  v_lshlrev_b32 v165, 16, v165
  v_lshlrev_b32 v166, 16, v166
  v_lshlrev_b32 v167, 16, v167
  v_lshlrev_b32 v168, 16, v168
  v_lshlrev_b32 v169, 16, v169
  v_lshlrev_b32 v170, 16, v170
  v_lshlrev_b32 v171, 16, v171
  v_lshlrev_b32 v172, 16, v172
  v_lshlrev_b32 v173, 16, v173
  v_lshlrev_b32 v174, 16, v174
  v_lshlrev_b32 v175, 16, v175
  v_lshlrev_b32 v176, 16, v176
  v_lshlrev_b32 v177, 16, v177
  v_lshlrev_b32 v178, 16, v178
  v_lshlrev_b32 v179, 16, v179
  v_lshlrev_b32 v180, 16, v180
  v_lshlrev_b32 v181, 16, v181
  v_lshlrev_b32 v182, 16, v182
  v_lshlrev_b32 v183, 16, v183
  v_lshlrev_b32 v184, 16, v184
  v_lshlrev_b32 v185, 16, v185
  v_lshlrev_b32 v186, 16, v186
  v_lshlrev_b32 v187, 16, v187
  v_lshlrev_b32 v188, 16, v188
  v_lshlrev_b32 v189, 16, v189
  v_lshlrev_b32 v190, 16, v190
  v_lshlrev_b32 v191, 16, v191
  v_lshlrev_b32 v100, 16, v100
  v_lshlrev_b32 v101, 16, v101
  v_lshlrev_b32 v102, 16, v102
  s_mov_b32 s37, 0
L_slow_b:
  s_cmp_eq_u32 s37, 0
  s_cselect_b32 s38, s44, s45
  s_cmp_eq_u32 s38, 0
  s_cbranch_scc1 L_slow_next
  s_lshl_b32 s39, s2, 4
  s_lshl_b32 s40, s52, 1
  s_add_u32 s39, s39, s40
  s_add_u32 s39, s39, s37
  s_mul_i32 s40, s39, 104
  v_lshlrev_b32 v5, 2, v1
  buffer_load_dword v6, v5, s[24:27], s40 offen
  s_mov_b32 s41, 0
  v_mov_b32 v7, v4
  s_waitcnt vmcnt(0)
L_slow_rows:
  v_readlane_b32 s42, v6, s41
  s_nop 3
  s_lshl_b32 s42, s42, 7
  buffer_load_ushort v8, v2, s[28:31], s42 offen
  s_waitcnt vmcnt(0)
  v_lshlrev_b32 v8, 16, v8
  ds_write_b32 v7, v8
  v_add_u32 v7, 256, v7
  s_add_u32 s41, s41, 1
  s_cmp_lt_u32 s41, 26
  s_cbranch_scc1 L_slow_rows
  v_mov_b32 v110, 0xff800000
  v_mov_b32 v111, 0
  v_mov_b32 v112, 0
  s_mov_b32 s41, 0
  s_waitcnt lgkmcnt(0)
L_slow_i:
  s_lshl_b32 s42, s41, 8
  v_add_u32 v7, s42, v4
  ds_read_b32 v103, v7
  s_add_u32 s43, s41, 1
L_slow_j:
  s_lshl_b32 s42, s43, 8
  v_add_u32 v7, s42, v4
  ds_read_b32 v104, v7
  s_waitcnt lgkmcnt(0)
  v_mul_f32 v105, v103, v104
  v_cvt_pk_bf16_f32 v105, v105, v105
  v_lshlrev_b32 v105, 16, v105
  v_mov_b32 v106, v100
  v_mul_f32 v107, v105, v102
  v_readlane_b32 s64, v105, 0
  v_readlane_b32 s65, v105, 1
  v_readlane_b32 s66, v105, 2
  v_readlane_b32 s67, v105, 3
  v_readlane_b32 s68, v105, 4
  v_readlane_b32 s69, v105, 5
  v_readlane_b32 s70, v105, 6
  v_readlane_b32 s71, v105, 7
  v_fma_f32 v106, s64, v128, v106
  v_fma_f32 v106, s65, v129, v106
  v_fma_f32 v106, s66, v130, v106
  v_fma_f32 v106, s67, v131, v106
  v_fma_f32 v106, s68, v132, v106
  v_fma_f32 v106, s69, v133, v106
  v_fma_f32 v106, s70, v134, v106
  v_fma_f32 v106, s71, v135, v106
  v_readlane_b32 s64, v105, 8
  v_readlane_b32 s65, v105, 9
  v_readlane_b32 s66, v105, 10
  v_readlane_b32 s67, v105, 11
  v_readlane_b32 s68, v105, 12
  v_readlane_b32 s69, v105, 13
  v_readlane_b32 s70, v105, 14
  v_readlane_b32 s71, v105, 15
  v_fma_f32 v106, s64, v136, v106
  v_fma_f32 v106, s65, v137, v106
  v_fma_f32 v106, s66, v138, v106
  v_fma_f32 v106, s67, v139, v106
  v_fma_f32 v106, s68, v140, v106
  v_fma_f32 v106, s69, v141, v106
  v_fma_f32 v106, s70, v142, v106
  v_fma_f32 v106, s71, v143, v106
  v_readlane_b32 s64, v105, 16
  v_readlane_b32 s65, v105, 17
  v_readlane_b32 s66, v105, 18
  v_readlane_b32 s67, v105, 19
  v_readlane_b32 s68, v105, 20
  v_readlane_b32 s69, v105, 21
  v_readlane_b32 s70, v105, 22
  v_readlane_b32 s71, v105, 23
  v_fma_f32 v106, s64, v144, v106
  v_fma_f32 v106, s65, v145, v106
  v_fma_f32 v106, s66, v146, v106
  v_fma_f32 v106, s67, v147, v106
  v_fma_f32 v106, s68, v148, v106
  v_fma_f32 v106, s69, v149, v106
  v_fma_f32 v106, s70, v150, v106
  v_fma_f32 v106, s71, v151, v106
  v_readlane_b32 s64, v105, 24
  v_readlane_b32 s65, v105, 25
  v_readlane_b32 s66, v105, 26
  v_readlane_b32 s67, v105, 27
  v_readlane_b32 s68, v105, 28
  v_readlane_b32 s69, v105, 29
  v_readlane_b32 s70, v105, 30
  v_readlane_b32 s71, v105, 31
  v_fma_f32 v106, s64, v152, v106
  v_fma_f32 v106, s65, v153, v106
  v_fma_f32 v106, s66, v154, v106
  v_fma_f32 v106, s67, v155, v106
  v_fma_f32 v106, s68, v156, v106
  v_fma_f32 v106, s69, v157, v106
  v_fma_f32 v106, s70, v158, v106
  v_fma_f32 v106, s71, v159, v106
  v_readlane_b32 s64, v105, 32
  v_readlane_b32 s65, v105, 33
  v_readlane_b32 s66, v105, 34
  v_readlane_b32 s67, v105, 35
  v_readlane_b32 s68, v105, 36
  v_readlane_b32 s69, v105, 37
  v_readlane_b32 s70, v105, 38
  v_readlane_b32 s71, v105, 39
  v_fma_f32 v106, s64, v160, v106
  v_fma_f32 v106, s65, v161, v106
  v_fma_f32 v106, s66, v162, v106
  v_fma_f32 v106, s67, v163, v106
  v_fma_f32 v106, s68, v164, v106
  v_fma_f32 v106, s69, v165, v106
  v_fma_f32 v106, s70, v166, v106
  v_fma_f32 v106, s71, v167, v106
  v_readlane_b32 s64, v105, 40
  v_readlane_b32 s65, v105, 41
  v_readlane_b32 s66, v105, 42
  v_readlane_b32 s67, v105, 43
  v_readlane_b32 s68, v105, 44
  v_readlane_b32 s69, v105, 45
  v_readlane_b32 s70, v105, 46
  v_readlane_b32 s71, v105, 47
  v_fma_f32 v106, s64, v168, v106
  v_fma_f32 v106, s65, v169, v106
  v_fma_f32 v106, s66, v170, v106
  v_fma_f32 v106, s67, v171, v106
  v_fma_f32 v106, s68, v172, v106
  v_fma_f32 v106, s69, v173, v106
  v_fma_f32 v106, s70, v174, v106
  v_fma_f32 v106, s71, v175, v106
  v_readlane_b32 s64, v105, 48
  v_readlane_b32 s65, v105, 49
  v_readlane_b32 s66, v105, 50
  v_readlane_b32 s67, v105, 51
  v_readlane_b32 s68, v105, 52
  v_readlane_b32 s69, v105, 53
  v_readlane_b32 s70, v105, 54
  v_readlane_b32 s71, v105, 55
  v_fma_f32 v106, s64, v176, v106
  v_fma_f32 v106, s65, v177, v106
  v_fma_f32 v106, s66, v178, v106
  v_fma_f32 v106, s67, v179, v106
  v_fma_f32 v106, s68, v180, v106
  v_fma_f32 v106, s69, v181, v106
  v_fma_f32 v106, s70, v182, v106
  v_fma_f32 v106, s71, v183, v106
  v_readlane_b32 s64, v105, 56
  v_readlane_b32 s65, v105, 57
  v_readlane_b32 s66, v105, 58
  v_readlane_b32 s67, v105, 59
  v_readlane_b32 s68, v105, 60
  v_readlane_b32 s69, v105, 61
  v_readlane_b32 s70, v105, 62
  v_readlane_b32 s71, v105, 63
  v_fma_f32 v106, s64, v184, v106
  v_fma_f32 v106, s65, v185, v106
  v_fma_f32 v106, s66, v186, v106
  v_fma_f32 v106, s67, v187, v106
  v_fma_f32 v106, s68, v188, v106
  v_fma_f32 v106, s69, v189, v106
  v_fma_f32 v106, s70, v190, v106
  v_fma_f32 v106, s71, v191, v106
  v_max_f32 v106, 0, v106
  v_mul_f32 v106, v106, v101
  s_nop 1
  v_add_f32_dpp v106, v106, v106 quad_perm:[1,0,3,2] row_mask:0xf bank_mask:0xf
  v_add_f32_dpp v107, v107, v107 quad_perm:[1,0,3,2] row_mask:0xf bank_mask:0xf
  s_nop 0
  v_add_f32_dpp v106, v106, v106 quad_perm:[2,3,0,1] row_mask:0xf bank_mask:0xf
  v_add_f32_dpp v107, v107, v107 quad_perm:[2,3,0,1] row_mask:0xf bank_mask:0xf
  s_nop 0
  v_add_f32_dpp v106, v106, v106 row_half_mirror row_mask:0xf bank_mask:0xf
  v_add_f32_dpp v107, v107, v107 row_half_mirror row_mask:0xf bank_mask:0xf
  s_nop 0
  v_add_f32_dpp v106, v106, v106 row_mirror row_mask:0xf bank_mask:0xf
  v_add_f32_dpp v107, v107, v107 row_mirror row_mask:0xf bank_mask:0xf
  s_nop 0
  v_mov_b32 v108, v106
  v_mov_b32 v109, v107
  s_nop 1
  v_permlane16_swap_b32 v106, v108
  v_permlane16_swap_b32 v107, v109
  s_nop 1
  v_add_f32 v106, v106, v108
  v_add_f32 v107, v107, v109
  v_mov_b32 v108, v106
  v_mov_b32 v109, v107
  s_nop 1
  v_permlane32_swap_b32 v106, v108
  v_permlane32_swap_b32 v107, v109
  s_nop 1
  v_add_f32 v106, v106, v108
  v_add_f32 v107, v107, v109
  v_mul_f32 v106, 0x3fb8aa3b, v106
  v_max_f32 v108, v110, v106
  v_sub_f32 v109, v110, v108
  v_sub_f32 v106, v106, v108
  v_exp_f32 v109, v109
  v_exp_f32 v106, v106
  v_mov_b32 v110, v108
  s_nop 0
  v_mul_f32 v111, v111, v109
  v_mul_f32 v112, v112, v109
  v_add_f32 v111, v111, v106
  v_fma_f32 v112, v106, v107, v112
  s_add_u32 s43, s43, 1
  s_cmp_lt_u32 s43, 26
  s_cbranch_scc1 L_slow_j
  s_add_u32 s41, s41, 1
  s_cmp_lt_u32 s41, 25
  s_cbranch_scc1 L_slow_i
  v_rcp_f32 v111, v111
  s_lshl_b32 s39, s39, 1
  v_mov_b32 v7, s39
  v_mul_f32 v112, v112, v111
  v_cvt_pk_bf16_f32 v112, v112, v112
  s_waitcnt vmcnt(0)
  s_mov_b64 exec, 1
  buffer_store_short v112, v7, s[48:51], 0 offen
  s_mov_b64 exec, -1
L_slow_next:
  s_add_u32 s37, s37, 1
  s_cmp_lt_u32 s37, 2
  s_cbranch_scc1 L_slow_b
  s_endpgm
.p2align 6
.type L_tbl,@object
L_tbl:
  .long 0x0, 0x8800880, 0x66001980, 0x6e802a80, 0x77003300, 0x7f803b80, 0xaa004400, 0xb2804c80, 0xbb005500, 0xc3805d80, 0xcc00d480, 0x22001100, 0x22001100, 0xb, 0xffff0000, 0x1
  .long 0x44003300, 0x4c803b80, 0x55004400, 0x5d804c80, 0x66005500, 0x6e805d80, 0x77006600, 0x7f806e80, 0x88007700, 0x90807f80, 0x99008800, 0xa1809080, 0xa1809080, 0xb, 0x0, 0xffff
  .long 0x66005500, 0x6e805d80, 0x77006600, 0x7f806e80, 0x88007700, 0x90807f80, 0x99008800, 0xa1809080, 0xaa009900, 0xb280a180, 0xbb00aa00, 0xc380b280, 0xc380b280, 0xb, 0x0, 0xffff
  .long 0x88007700, 0x90807f80, 0x8800, 0x8809080, 0x99009900, 0xa180a180, 0xaa00aa00, 0xb280b280, 0xbb00bb00, 0xc380c380, 0xcc00cc00, 0xd480d480, 0xd480d480, 0xb, 0x0, 0xffff
  .long 0xaa009900, 0xb280a180, 0x11000000, 0x19800880, 0x33003300, 0x3b803b80, 0x4400aa00, 0x4c80b280, 0xbb00bb00, 0xc380c380, 0xcc00cc00, 0xd480d480, 0xd480d480, 0xb, 0x0, 0xffff
  .long 0xcc00bb00, 0xd480c380, 0x2a801980, 0x33003300, 0x3b803b80, 0x44004400, 0x4c804c80, 0x55005500, 0x5d805d80, 0x6600cc00, 0x6e80d480, 0x22001100, 0x22001100, 0xb, 0x0, 0x1
  .long 0x22001100, 0x2a801980, 0x33002200, 0x3b802a80, 0x44003300, 0x4c803b80, 0x55004400, 0x5d804c80, 0x66005500, 0x6e805d80, 0x77006600, 0xd480c380, 0xd480c380, 0xb, 0x0, 0x1
  .long 0x22001100, 0x2a801980, 0x7f806e80, 0x88007700, 0x90807f80, 0x99008800, 0xa1809080, 0xaa009900, 0xb280a180, 0xbb00cc00, 0xc380d480, 0x8800880, 0x8800880, 0xb, 0xffffffff, 0x1
.section .rodata,"a"
.p2align 6
.amdhsa_kernel standalone__factorization_afm__recsys_kernel
  .amdhsa_next_free_vgpr 256
  .amdhsa_next_free_sgpr 102
  .amdhsa_accum_offset 256
  .amdhsa_group_segment_fixed_size 0
  .amdhsa_kernarg_size 88
  .amdhsa_user_sgpr_count 2
  .amdhsa_user_sgpr_kernarg_segment_ptr 1
  .amdhsa_system_sgpr_workgroup_id_x 1
.end_amdhsa_kernel
```
